```python
import torch

def _softmax(x, axis=-1):
    return torch.softmax(x, dim=axis)
def _gelu(x):
    return torch.nn.functional.gelu(x, approximate="tanh")
def _silu(x):
    return torch.nn.functional.silu(x)
def _sigmoid(x):
    return torch.sigmoid(x)
def _layernorm(x, axis=-1, eps=1e-5):
    m = x.mean(dim=axis, keepdim=True)
    v = x.var(dim=axis, keepdim=True, unbiased=False)
    return (x - m) / torch.sqrt(v + eps)
def _scatter_add(tgt, idx, src, axis=0):
    return tgt.clone().index_add_(axis, idx, src)
def _segment_sum(src, seg, n):
    out = torch.zeros((n,) + src.shape[1:], dtype=src.dtype)
    return out.index_add_(0, seg, src)
def _pad(x, pw):
    flat = tuple(v for pair in reversed(pw) for v in pair)
    return torch.nn.functional.pad(x, flat)

kernel_name = 'gated_mix__sliding_block_cached__sliding_block_cached__decode'

def setup_inputs():

    _w = (lambda a: (lambda t: t.to(torch.bfloat16) if t.is_floating_point() else t)(torch.as_tensor(a)))
    def _A_setup():
        B, Sq, D = 1, 1, 512
        Hq, Hkv, Sk, Dh = 32, 8, 32768, 128
        assert Hq % Hkv == 0, (Hq, Hkv)
        return {
            "x": _w((lambda *s: torch.randn(*s, dtype=torch.bfloat16) * 0.05)(B, Sq, D)),
            "k_cache": _w((lambda *s: torch.randn(*s, dtype=torch.bfloat16) * 6.4)(B, Hkv, Sk, Dh)),
            "v_cache": _w((lambda *s: torch.randn(*s, dtype=torch.bfloat16) * 0.05)(B, Hkv, Sk, Dh)),
            "wq": _w((lambda *s: torch.randn(*s, dtype=torch.bfloat16) * 6.4)(D, Hq * Dh) * (D ** -0.5)),
            "wo": _w((lambda *s: torch.randn(*s, dtype=torch.bfloat16) * 0.05)(Hq * Dh, D) * ((Hq * Dh) ** -0.5)),
        }
    _A_in = _A_setup()

    def _B_setup():
        B, Sq, D = 1, 1, 512
        Hq, Hkv, Sk, Dh = 32, 8, 32768, 128
        assert Hq % Hkv == 0, (Hq, Hkv)
        return {
            "x": _w((lambda *s: torch.randn(*s, dtype=torch.bfloat16) * 0.05)(B, Sq, D)),
            "k_cache": _w((lambda *s: torch.randn(*s, dtype=torch.bfloat16) * 6.4)(B, Hkv, Sk, Dh)),
            "v_cache": _w((lambda *s: torch.randn(*s, dtype=torch.bfloat16) * 0.05)(B, Hkv, Sk, Dh)),
            "wq": _w((lambda *s: torch.randn(*s, dtype=torch.bfloat16) * 6.4)(D, Hq * Dh) * (D ** -0.5)),
            "wo": _w((lambda *s: torch.randn(*s, dtype=torch.bfloat16) * 0.05)(Hq * Dh, D) * ((Hq * Dh) ** -0.5)),
        }
    _B_in = _B_setup()

    return {
        "A_x": _A_in["x"],
        "A_k_cache": _A_in["k_cache"],
        "A_v_cache": _A_in["v_cache"],
        "A_wq": _A_in["wq"],
        "A_wo": _A_in["wo"],
        "B_x": _B_in["x"],
        "B_k_cache": _B_in["k_cache"],
        "B_v_cache": _B_in["v_cache"],
        "B_wq": _B_in["wq"],
        "B_wo": _B_in["wo"],
        "gate_w": _w((lambda *s: torch.randn(*s, dtype=torch.bfloat16) * 0.05)(512) * 16.0),
    }

def reference(A_x, A_k_cache, A_v_cache, A_wq, A_wo, B_x, B_k_cache, B_v_cache, B_wq, B_wo, gate_w):
    def _A_ref(x, k_cache, v_cache, wq, wo):
        B, Sq, D = x.shape
        Hq, Dh = 32, 128
        Hkv, Sk = k_cache.shape[1], k_cache.shape[2]
        W = min(4096, max(256, Sk // 4))
        rep = Hq // Hkv
        q = (lambda x, *d: x.permute(*d))((x @ wq).reshape(B, Sq, Hq, Dh), 0, 2, 1, 3)
        k = (lambda x, n, axis: torch.repeat_interleave(x, n, dim=axis))(k_cache[:, :, Sk - W:, :], rep, axis=1)
        v = (lambda x, n, axis: torch.repeat_interleave(x, n, dim=axis))(v_cache[:, :, Sk - W:, :], rep, axis=1)
        scores = torch.einsum("bhqd,bhkd->bhqk", q, k) * (Dh ** -0.5)
        p = _softmax(scores, axis=-1)
        o = torch.einsum("bhqk,bhkd->bhqd", p, v)
        return (lambda x, *d: x.permute(*d))(o, 0, 2, 1, 3).reshape(B, Sq, Hq * Dh) @ wo

    def _B_ref(x, k_cache, v_cache, wq, wo):
        B, Sq, D = x.shape
        Hq, Dh = 32, 128
        Hkv, Sk = k_cache.shape[1], k_cache.shape[2]
        W = min(4096, max(256, Sk // 4))
        rep = Hq // Hkv
        q = (lambda x, *d: x.permute(*d))((x @ wq).reshape(B, Sq, Hq, Dh), 0, 2, 1, 3)
        k = (lambda x, n, axis: torch.repeat_interleave(x, n, dim=axis))(k_cache[:, :, Sk - W:, :], rep, axis=1)
        v = (lambda x, n, axis: torch.repeat_interleave(x, n, dim=axis))(v_cache[:, :, Sk - W:, :], rep, axis=1)
        scores = torch.einsum("bhqd,bhkd->bhqk", q, k) * (Dh ** -0.5)
        p = _softmax(scores, axis=-1)
        o = torch.einsum("bhqk,bhkd->bhqd", p, v)
        return (lambda x, *d: x.permute(*d))(o, 0, 2, 1, 3).reshape(B, Sq, Hq * Dh) @ wo

    x = A_x
    g = _sigmoid((x * gate_w).sum(-1, keepdims=True))
    a = _A_ref(x, A_k_cache, A_v_cache, A_wq, A_wo)
    b = _B_ref(x, B_k_cache, B_v_cache, B_wq, B_wo)
    return g * a + (1 - g) * b
```

```asm
; @launch grid=(256,1,1) block=(256,1,1) lds=14336
.amdgcn_target "amdgcn-amd-amdhsa--gfx950"
.text
.globl gated_mix__sliding_block_cached__sliding_block_cached__decode_kernel
.p2align 8
.type gated_mix__sliding_block_cached__sliding_block_cached__decode_kernel,@function
gated_mix__sliding_block_cached__sliding_block_cached__decode_kernel:
    s_cmp_ge_u32 s2, 256
    s_cbranch_scc1 L_END
    s_load_dwordx16 s[4:19], s[0:1], 0
    s_load_dwordx8 s[20:27], s[0:1], 64
    s_load_dwordx4 s[28:31], s[0:1], 96
    v_and_b32 v1, 63, v0
    v_lshrrev_b32 v20, 4, v0
    v_and_b32 v21, 15, v0
    v_lshlrev_b32 v21, 4, v21
    v_lshl_or_b32 v2, v20, 16, v21
    v_and_b32 v22, 7, v0
    v_lshlrev_b32 v22, 1, v22
    v_lshl_or_b32 v6, v20, 4, v22
    v_lshlrev_b32 v19, 4, v1
    v_lshrrev_b32 v20, 6, v0
    v_lshl_or_b32 v4, v20, 12, v19
    v_and_b32 v22, 3, v1
    v_lshlrev_b32 v22, 4, v22
    v_bfe_u32 v23, v1, 2, 2
    v_lshl_or_b32 v22, v23, 8, v22
    v_lshrrev_b32 v23, 4, v1
    v_lshl_or_b32 v22, v23, 6, v22
    v_lshl_or_b32 v3, v20, 12, v22
    v_readfirstlane_b32 s77, v20
    s_and_b32 s75, s2, 15
    s_lshr_b32 s76, s2, 4
    s_and_b32 s85, s2, 7
    s_lshr_b32 s86, s2, 6
    s_and_b32 s87, s76, 3
    s_lshl_b32 s98, s85, 2
    s_add_u32 s98, s98, s87
    s_lshl_b32 s98, s98, 8
    s_lshl_b32 s99, s86, 20
    s_add_u32 s98, s98, s99
    s_lshl_b32 s99, s85, 23
    s_lshl_b32 s84, s76, 16
    s_add_u32 s99, s99, s84
    s_add_u32 s99, s99, 7340032
    s_lshl_b32 s96, s86, 8
    s_mov_b32 s81, s2
    s_lshl_b32 s68, s75, 3
    s_lshr_b32 s84, s76, 1
    s_add_u32 s68, s68, s84
    s_mov_b32 s64, 4096
    s_mov_b32 s65, 8192
    s_mov_b32 s66, 12288
    s_mov_b32 s67, 16384
    s_mov_b32 s69, 24576
    s_mov_b32 s71, 32768
    s_mov_b32 s72, 40960
    s_mov_b32 s73, 49152
    s_mov_b32 s74, 57344
    s_mov_b32 s34, 1048576
    s_mov_b32 s35, 0x00020000
    s_mov_b32 s38, 65536
    s_mov_b32 s39, 0x00020000
    s_mov_b32 s42, 65536
    s_mov_b32 s43, 0x00020000
    s_mov_b32 s46, 1024
    s_mov_b32 s47, 0x00020000
    s_mov_b32 s50, 2097152
    s_mov_b32 s51, 0x00020000
    s_mov_b32 s54, 65024
    s_mov_b32 s55, 0x00020000
    s_mov_b32 s58, 1024
    s_mov_b32 s59, 0x00020000
    s_mov_b32 s62, 1024
    s_mov_b32 s63, 0x00020000
    s_waitcnt lgkmcnt(0)
    s_load_dword s78, s[30:31], 0
    s_mov_b64 s[44:45], s[4:5]
    s_bitcmp1_b32 s2, 3
    s_cselect_b64 s[32:33], s[20:21], s[10:11]
    s_cselect_b64 s[36:37], s[16:17], s[6:7]
    s_cselect_b64 s[40:41], s[18:19], s[8:9]
    s_cselect_b64 s[52:53], s[22:23], s[12:13]
    s_mov_b64 s[56:57], s[24:25]
    s_cmp_ge_u32 s81, 16
    s_cbranch_scc1 L_GL_DONE
    buffer_load_dwordx4 v[248:251], v19, s[44:47], 0 offen
    buffer_load_dwordx4 v[252:255], v19, s[56:59], 0 offen
L_GL_DONE:
    buffer_load_ushort v27, v6, s[44:47], s96 offen
    s_add_u32 s32, s32, s98
    s_addc_u32 s33, s33, 0
    buffer_load_dwordx4 v[32:35], v2, s[32:35], 0 offen nt
    buffer_load_dwordx4 v[36:39], v2, s[32:35], s65 offen nt
    buffer_load_dwordx4 v[40:43], v2, s[32:35], s67 offen nt
    buffer_load_dwordx4 v[44:47], v2, s[32:35], s69 offen nt
    buffer_load_dwordx4 v[48:51], v2, s[32:35], s71 offen nt
    buffer_load_dwordx4 v[52:55], v2, s[32:35], s72 offen nt
    buffer_load_dwordx4 v[56:59], v2, s[32:35], s73 offen nt
    buffer_load_dwordx4 v[60:63], v2, s[32:35], s74 offen nt
    s_add_u32 s36, s36, s99
    s_addc_u32 s37, s37, 0
    s_add_u32 s40, s40, s99
    s_addc_u32 s41, s41, 0
    s_mov_b64 s[48:49], s[30:31]
    buffer_load_dwordx4 v[64:67], v3, s[36:39], 0 offen offset:0 nt
    v_and_b32 v21, 1, v1
    v_lshlrev_b32 v21, 4, v21
    s_mov_b32 s98, 0xffff
    v_lshlrev_b32_e64 v21, v21, s98
    v_bfe_u32 v22, v1, 1, 3
    v_cmp_eq_u32 vcc, 0, v22
    s_nop 1
    v_cndmask_b32 v8, 0, v21, vcc
    v_cmp_eq_u32 vcc, 1, v22
    s_nop 1
    v_cndmask_b32 v9, 0, v21, vcc
    v_cmp_eq_u32 vcc, 2, v22
    s_nop 1
    v_cndmask_b32 v10, 0, v21, vcc
    v_cmp_eq_u32 vcc, 3, v22
    s_nop 1
    v_cndmask_b32 v11, 0, v21, vcc
    v_cmp_eq_u32 vcc, 4, v22
    s_nop 1
    v_cndmask_b32 v28, 0, v21, vcc
    v_cmp_eq_u32 vcc, 5, v22
    s_nop 1
    v_cndmask_b32 v29, 0, v21, vcc
    v_cmp_eq_u32 vcc, 6, v22
    s_nop 1
    v_cndmask_b32 v30, 0, v21, vcc
    v_cmp_eq_u32 vcc, 7, v22
    s_nop 1
    v_cndmask_b32 v31, 0, v21, vcc
    s_mov_b64 s[60:61], s[26:27]
    s_and_b32 s98, s68, 63
    s_lshl_b32 s98, s98, 16
    s_and_b32 s99, s76, 1
    s_lshl_b32 s99, s99, 9
    s_add_u32 s98, s98, s99
    s_add_u32 s52, s52, s98
    s_addc_u32 s53, s53, 0
    s_lshl_b32 s89, s75, 14
    s_add_u32 s89, s89, 65536
    s_lshl_b32 s98, s87, 12
    s_lshl_b32 s99, s86, 9
    s_add_u32 s88, s89, s98
    s_add_u32 s88, s88, s99
    s_lshl_b32 s98, s75, 2
    s_add_u32 s99, s98, s77
    s_lshl_b32 s99, s99, 4
    s_add_u32 s99, s99, s76
    s_mul_i32 s90, s99, 640
    s_add_u32 s90, s90, 327680
    s_add_u32 s99, s98, s86
    s_mul_i32 s93, s99, 10240
    s_add_u32 s93, s93, 327680
    s_bfe_u32 s99, s76, 65537
    s_lshl_b32 s99, s99, 2
    s_add_u32 s99, s99, s77
    s_lshl_b32 s99, s99, 6
    s_add_u32 s91, s93, s99
    s_add_u32 s93, s93, 512
    s_and_b32 s99, s76, 1
    s_lshl_b32 s94, s99, 10
    s_lshl_b32 s99, s68, 11
    s_add_u32 s94, s94, s99
    s_add_u32 s94, s94, 983040
    s_lshl_b32 s99, s81, 7
    s_lshl_b32 s95, s77, 16
    s_add_u32 s95, s95, s99
    s_add_u32 s95, s95, 983040
    s_mov_b32 s79, 0xffffff00
    s_mov_b32 s80, 0x3fb8aa3b
    s_mov_b32 s82, 0x3db504f3
    s_mov_b32 s83, 0x3db504f3
    s_mov_b32 s97, 0xffff0000
    s_mov_b32 s84, 20000
    v_mov_b32 v20, s77
    v_and_b32 v21, 15, v1
    v_lshlrev_b32 v21, 5, v21
    v_lshrrev_b32 v22, 4, v1
    v_lshl_or_b32 v21, v22, 4, v21
    v_lshl_or_b32 v12, v20, 9, v21
    v_and_b32 v21, 31, v1
    v_lshlrev_b32 v21, 3, v21
    v_lshrrev_b32 v23, 5, v1
    v_lshl_or_b32 v21, v23, 1, v21
    s_mul_i32 s98, s77, 272
    s_add_u32 s98, s98, 4096
    v_add_u32 v13, s98, v21
    v_and_b32 v21, 3, v1
    v_mul_u32_u24 v23, 272, v21
    v_lshrrev_b32 v14, 2, v1
    v_lshl_add_u32 v14, v14, 4, v23
    v_add_u32 v14, 4096, v14
    v_lshlrev_b32 v15, 2, v21
    v_add_u32 v15, 5248, v15
    s_lshl_b32 s98, s77, 2
    s_add_u32 s98, s98, 5280
    v_lshlrev_b32 v16, 4, v21
    v_add_u32 v16, s98, v16
    v_mul_u32_u24 v23, 544, v21
    v_lshl_add_u32 v23, v22, 7, v23
    v_bfe_u32 v21, v1, 2, 2
    v_lshl_add_u32 v23, v21, 3, v23
    s_mul_i32 s98, s77, 2176
    s_add_u32 s98, s98, 5376
    v_add_u32 v17, s98, v23
    s_mul_i32 s98, s77, 544
    s_add_u32 s98, s98, 5376
    v_add_u32 v18, s98, v19
    v_and_b32 v21, 1, v22
    v_lshlrev_b32 v21, 1, v21
    v_lshrrev_b32 v23, 1, v22
    v_or_b32 v21, v21, v23
    v_and_b32 v23, 15, v1
    v_lshlrev_b32 v23, 4, v23
    v_lshl_or_b32 v23, v21, 10, v23
    v_lshl_or_b32 v7, v20, 14, v23
    v_mov_b32 v21, 0xff800000
    ds_write_b32 v15, v21
    s_waitcnt vmcnt(9)
    v_lshl_or_b32 v27, v27, 16, v27
    s_nop 1
    v_and_b32_dpp v192, v27, v8 row_newbcast:0 row_mask:0xf bank_mask:0xf
    v_and_b32_dpp v193, v27, v9 row_newbcast:0 row_mask:0xf bank_mask:0xf
    v_and_b32_dpp v194, v27, v10 row_newbcast:0 row_mask:0xf bank_mask:0xf
    v_and_b32_dpp v195, v27, v11 row_newbcast:0 row_mask:0xf bank_mask:0xf
    v_and_b32_dpp v196, v27, v8 row_newbcast:1 row_mask:0xf bank_mask:0xf
    v_and_b32_dpp v197, v27, v9 row_newbcast:1 row_mask:0xf bank_mask:0xf
    v_and_b32_dpp v198, v27, v10 row_newbcast:1 row_mask:0xf bank_mask:0xf
    v_and_b32_dpp v199, v27, v11 row_newbcast:1 row_mask:0xf bank_mask:0xf
    v_and_b32_dpp v200, v27, v8 row_newbcast:2 row_mask:0xf bank_mask:0xf
    v_and_b32_dpp v201, v27, v9 row_newbcast:2 row_mask:0xf bank_mask:0xf
    v_and_b32_dpp v202, v27, v10 row_newbcast:2 row_mask:0xf bank_mask:0xf
    v_and_b32_dpp v203, v27, v11 row_newbcast:2 row_mask:0xf bank_mask:0xf
    v_and_b32_dpp v204, v27, v8 row_newbcast:3 row_mask:0xf bank_mask:0xf
    v_and_b32_dpp v205, v27, v9 row_newbcast:3 row_mask:0xf bank_mask:0xf
    v_and_b32_dpp v206, v27, v10 row_newbcast:3 row_mask:0xf bank_mask:0xf
    v_and_b32_dpp v207, v27, v11 row_newbcast:3 row_mask:0xf bank_mask:0xf
    v_and_b32_dpp v208, v27, v8 row_newbcast:4 row_mask:0xf bank_mask:0xf
    v_and_b32_dpp v209, v27, v9 row_newbcast:4 row_mask:0xf bank_mask:0xf
    v_and_b32_dpp v210, v27, v10 row_newbcast:4 row_mask:0xf bank_mask:0xf
    v_and_b32_dpp v211, v27, v11 row_newbcast:4 row_mask:0xf bank_mask:0xf
    v_and_b32_dpp v212, v27, v8 row_newbcast:5 row_mask:0xf bank_mask:0xf
    v_and_b32_dpp v213, v27, v9 row_newbcast:5 row_mask:0xf bank_mask:0xf
    v_and_b32_dpp v214, v27, v10 row_newbcast:5 row_mask:0xf bank_mask:0xf
    v_and_b32_dpp v215, v27, v11 row_newbcast:5 row_mask:0xf bank_mask:0xf
    v_and_b32_dpp v216, v27, v8 row_newbcast:6 row_mask:0xf bank_mask:0xf
    v_and_b32_dpp v217, v27, v9 row_newbcast:6 row_mask:0xf bank_mask:0xf
    v_and_b32_dpp v218, v27, v10 row_newbcast:6 row_mask:0xf bank_mask:0xf
    v_and_b32_dpp v219, v27, v11 row_newbcast:6 row_mask:0xf bank_mask:0xf
    v_and_b32_dpp v220, v27, v8 row_newbcast:7 row_mask:0xf bank_mask:0xf
    v_and_b32_dpp v221, v27, v9 row_newbcast:7 row_mask:0xf bank_mask:0xf
    v_and_b32_dpp v222, v27, v10 row_newbcast:7 row_mask:0xf bank_mask:0xf
    v_and_b32_dpp v223, v27, v11 row_newbcast:7 row_mask:0xf bank_mask:0xf
    s_waitcnt vmcnt(8)
    v_mfma_f32_16x16x32_bf16 v[24:27], v[192:195], v[32:35], 0
    buffer_load_dwordx4 v[68:71], v3, s[36:39], 0 offen offset:1024 nt
    s_waitcnt vmcnt(8)
    v_mfma_f32_16x16x32_bf16 v[24:27], v[196:199], v[36:39], v[24:27]
    buffer_load_dwordx4 v[72:75], v3, s[36:39], 0 offen offset:2048 nt
    s_waitcnt vmcnt(8)
    v_mfma_f32_16x16x32_bf16 v[24:27], v[200:203], v[40:43], v[24:27]
    buffer_load_dwordx4 v[76:79], v3, s[36:39], 0 offen offset:3072 nt
    s_waitcnt vmcnt(8)
    v_mfma_f32_16x16x32_bf16 v[24:27], v[204:207], v[44:47], v[24:27]
    buffer_load_dwordx4 v[80:83], v3, s[36:39], s67 offen offset:0 nt
    s_waitcnt vmcnt(8)
    v_mfma_f32_16x16x32_bf16 v[24:27], v[208:211], v[48:51], v[24:27]
    buffer_load_dwordx4 v[84:87], v3, s[36:39], s67 offen offset:1024 nt
    s_waitcnt vmcnt(8)
    v_mfma_f32_16x16x32_bf16 v[24:27], v[212:215], v[52:55], v[24:27]
    buffer_load_dwordx4 v[88:91], v3, s[36:39], s67 offen offset:2048 nt
    s_waitcnt vmcnt(8)
    v_mfma_f32_16x16x32_bf16 v[24:27], v[216:219], v[56:59], v[24:27]
    buffer_load_dwordx4 v[92:95], v3, s[36:39], s67 offen offset:3072 nt
    s_waitcnt vmcnt(8)
    v_mfma_f32_16x16x32_bf16 v[24:27], v[220:223], v[60:63], v[24:27]
    buffer_load_dwordx4 v[96:99], v3, s[36:39], s71 offen offset:0 nt
    s_mov_b32 exec_hi, 0
    s_nop 5
    ds_write_b128 v12, v[24:27] offset:0
    s_mov_b32 exec_hi, -1
    s_waitcnt lgkmcnt(0)
    s_barrier
    s_add_u32 s78, s78, 1
    s_and_b32 s98, s78, 0xff
    v_mov_b32 v5, s98
    s_cmp_lg_u32 s77, 0
    s_cbranch_scc1 L_QPUB_DONE
    s_mov_b32 exec_hi, 0
    ds_read_b128 v[192:195], v19 offset:0
    ds_read_b128 v[196:199], v19 offset:512
    ds_read_b128 v[200:203], v19 offset:1024
    ds_read_b128 v[204:207], v19 offset:1536
    s_waitcnt lgkmcnt(0)
    v_pk_add_f32 v[192:193], v[192:193], v[196:197]
    v_pk_add_f32 v[194:195], v[194:195], v[198:199]
    v_pk_add_f32 v[200:201], v[200:201], v[204:205]
    v_pk_add_f32 v[202:203], v[202:203], v[206:207]
    v_pk_add_f32 v[192:193], v[192:193], v[200:201]
    v_pk_add_f32 v[194:195], v[194:195], v[202:203]
    v_and_or_b32 v192, v192, s79, v5
    v_and_or_b32 v193, v193, s79, v5
    v_and_or_b32 v194, v194, s79, v5
    v_and_or_b32 v195, v195, s79, v5
    buffer_store_dwordx4 v[192:195], v19, s[48:51], s88 offen sc1
    s_mov_b32 exec_hi, -1
L_QPUB_DONE:
    s_nop 1
    s_cmp_ge_u32 s81, 16
    s_cbranch_scc1 L_GATE_DONE
    v_mov_b32 v174, 0
    v_lshlrev_b32 v168, 16, v248
    v_and_b32 v169, s97, v248
    v_lshlrev_b32 v170, 16, v252
    v_and_b32 v171, s97, v252
    v_pk_mul_f32 v[168:169], v[168:169], v[170:171]
    v_cvt_pk_bf16_f32 v172, v168, v169
    v_lshlrev_b32 v168, 16, v172
    v_and_b32 v169, s97, v172
    v_add_f32 v174, v174, v168
    v_add_f32 v174, v174, v169
    v_lshlrev_b32 v168, 16, v249
    v_and_b32 v169, s97, v249
    v_lshlrev_b32 v170, 16, v253
    v_and_b32 v171, s97, v253
    v_pk_mul_f32 v[168:169], v[168:169], v[170:171]
    v_cvt_pk_bf16_f32 v172, v168, v169
    v_lshlrev_b32 v168, 16, v172
    v_and_b32 v169, s97, v172
    v_add_f32 v174, v174, v168
    v_add_f32 v174, v174, v169
    v_lshlrev_b32 v168, 16, v250
    v_and_b32 v169, s97, v250
    v_lshlrev_b32 v170, 16, v254
    v_and_b32 v171, s97, v254
    v_pk_mul_f32 v[168:169], v[168:169], v[170:171]
    v_cvt_pk_bf16_f32 v172, v168, v169
    v_lshlrev_b32 v168, 16, v172
    v_and_b32 v169, s97, v172
    v_add_f32 v174, v174, v168
    v_add_f32 v174, v174, v169
    v_lshlrev_b32 v168, 16, v251
    v_and_b32 v169, s97, v251
    v_lshlrev_b32 v170, 16, v255
    v_and_b32 v171, s97, v255
    v_pk_mul_f32 v[168:169], v[168:169], v[170:171]
    v_cvt_pk_bf16_f32 v172, v168, v169
    v_lshlrev_b32 v168, 16, v172
    v_and_b32 v169, s97, v172
    v_add_f32 v174, v174, v168
    v_add_f32 v174, v174, v169
    s_nop 1
    v_add_f32_dpp v174, v174, v174 row_ror:8 row_mask:0xf bank_mask:0xf
    s_nop 1
    v_add_f32_dpp v174, v174, v174 row_ror:4 row_mask:0xf bank_mask:0xf
    s_nop 1
    v_add_f32_dpp v174, v174, v174 row_ror:2 row_mask:0xf bank_mask:0xf
    s_nop 1
    v_add_f32_dpp v174, v174, v174 row_ror:1 row_mask:0xf bank_mask:0xf
    v_mov_b32 v168, v174
    s_nop 1
    v_permlane16_swap_b32 v174, v168
    v_add_f32 v174, v174, v168
    v_mov_b32 v168, v174
    s_nop 1
    v_permlane32_swap_b32 v174, v168
    v_add_f32 v174, v174, v168
    v_cvt_pk_bf16_f32 v174, v174, v174
    v_and_b32 v174, s97, v174
    v_mul_f32 v174, s80, v174
    v_exp_f32_e64 v174, -v174
    s_nop 0
    v_add_f32 v174, 1.0, v174
    v_rcp_f32 v174, v174
    s_nop 0
    v_cvt_pk_bf16_f32 v174, v174, v174
    v_and_b32 v248, s97, v174
    v_mov_b32 v249, v248
    v_sub_f32 v168, 1.0, v248
    v_cvt_pk_bf16_f32 v168, v168, v168
    v_and_b32 v250, s97, v168
    v_mov_b32 v251, v250
L_GATE_DONE:
    v_mov_b32 v208, 0
    v_mov_b32 v209, 0
    v_mov_b32 v210, 0
    v_mov_b32 v211, 0
    v_mov_b32 v212, 0
    v_mov_b32 v213, 0
    v_mov_b32 v214, 0
    v_mov_b32 v215, 0
    v_mov_b32 v216, 0
    v_mov_b32 v217, 0
    v_mov_b32 v218, 0
    v_mov_b32 v219, 0
    v_mov_b32 v220, 0
    v_mov_b32 v221, 0
    v_mov_b32 v222, 0
    v_mov_b32 v223, 0
    s_waitcnt vmcnt(8)
    buffer_load_dwordx4 v[100:103], v3, s[36:39], s71 offen offset:1024 nt
    s_waitcnt vmcnt(8)
    buffer_load_dwordx4 v[104:107], v3, s[36:39], s71 offen offset:2048 nt
    s_waitcnt vmcnt(8)
    buffer_load_dwordx4 v[108:111], v3, s[36:39], s71 offen offset:3072 nt
    s_waitcnt vmcnt(8)
    buffer_load_dwordx4 v[112:115], v3, s[36:39], s73 offen offset:0 nt
    s_waitcnt vmcnt(8)
    buffer_load_dwordx4 v[116:119], v3, s[36:39], s73 offen offset:1024 nt
    s_waitcnt vmcnt(8)
    buffer_load_dwordx4 v[120:123], v3, s[36:39], s73 offen offset:2048 nt
    s_waitcnt vmcnt(8)
    buffer_load_dwordx4 v[124:127], v3, s[36:39], s73 offen offset:3072 nt
    s_waitcnt vmcnt(8)
    buffer_load_dwordx4 v[32:35], v4, s[48:51], s89 offen offset:0 sc1
    buffer_load_dwordx4 v[36:39], v4, s[48:51], s89 offen offset:1024 sc1
    s_waitcnt vmcnt(8)
    buffer_load_dwordx4 v[128:131], v4, s[40:43], 0 offen offset:0 nt
    s_waitcnt vmcnt(8)
    buffer_load_dwordx4 v[132:135], v4, s[40:43], 0 offen offset:1024 nt
    s_waitcnt vmcnt(8)
    buffer_load_dwordx4 v[136:139], v4, s[40:43], 0 offen offset:2048 nt
    s_waitcnt vmcnt(8)
    buffer_load_dwordx4 v[40:43], v4, s[48:51], s89 offen offset:0 sc1
    buffer_load_dwordx4 v[44:47], v4, s[48:51], s89 offen offset:1024 sc1
    s_waitcnt vmcnt(8)
    buffer_load_dwordx4 v[140:143], v4, s[40:43], 0 offen offset:3072 nt
    s_waitcnt vmcnt(8)
    buffer_load_dwordx4 v[144:147], v4, s[40:43], s67 offen offset:0 nt
    s_waitcnt vmcnt(8)
    buffer_load_dwordx4 v[148:151], v4, s[40:43], s67 offen offset:1024 nt
    s_mov_b32 s85, 0
    s_waitcnt vmcnt(10)
    s_waitcnt vmcnt(8)
    v_xor_b32 v32, v32, v5
    v_xor_b32 v33, v33, v5
    v_xor_b32 v34, v34, v5
    v_xor_b32 v35, v35, v5
    v_xor_b32 v36, v36, v5
    v_xor_b32 v37, v37, v5
    v_xor_b32 v38, v38, v5
    v_xor_b32 v39, v39, v5
    v_or3_b32 v20, v32, v33, v34
    v_or3_b32 v20, v20, v35, v36
    v_or3_b32 v20, v20, v37, v38
    v_or_b32 v20, v20, v39
    v_cmp_ne_u32_sdwa vcc, v20, 0 src0_sel:BYTE_0 src1_sel:DWORD
    s_cbranch_vccz L_Q0
    buffer_load_dwordx4 v[32:35], v4, s[48:51], s89 offen offset:0 sc1
    buffer_load_dwordx4 v[36:39], v4, s[48:51], s89 offen offset:1024 sc1
    s_waitcnt vmcnt(10)
    buffer_load_dwordx4 v[152:155], v4, s[40:43], s67 offen offset:2048 nt
    s_waitcnt vmcnt(10)
    buffer_load_dwordx4 v[156:159], v4, s[40:43], s67 offen offset:3072 nt
    s_waitcnt vmcnt(10)
    buffer_load_dwordx4 v[160:163], v4, s[40:43], s71 offen offset:0 nt
    s_mov_b32 s85, 1
    s_waitcnt vmcnt(8)
    v_xor_b32 v40, v40, v5
    v_xor_b32 v41, v41, v5
    v_xor_b32 v42, v42, v5
    v_xor_b32 v43, v43, v5
    v_xor_b32 v44, v44, v5
    v_xor_b32 v45, v45, v5
    v_xor_b32 v46, v46, v5
    v_xor_b32 v47, v47, v5
    v_or3_b32 v20, v40, v41, v42
    v_or3_b32 v20, v20, v43, v44
    v_or3_b32 v20, v20, v45, v46
    v_or_b32 v20, v20, v47
    v_cmp_ne_u32_sdwa vcc, v20, 0 src0_sel:BYTE_0 src1_sel:DWORD
    s_cbranch_vccz L_Q1
    buffer_load_dwordx4 v[40:43], v4, s[48:51], s89 offen offset:0 sc1
    buffer_load_dwordx4 v[44:47], v4, s[48:51], s89 offen offset:1024 sc1
    s_waitcnt vmcnt(10)
    buffer_load_dwordx4 v[164:167], v4, s[40:43], s71 offen offset:1024 nt
    s_waitcnt vmcnt(10)
    buffer_load_dwordx4 v[168:171], v4, s[40:43], s71 offen offset:2048 nt
    s_waitcnt vmcnt(10)
    buffer_load_dwordx4 v[172:175], v4, s[40:43], s71 offen offset:3072 nt
    s_mov_b32 s85, 2
    s_waitcnt vmcnt(8)
    v_xor_b32 v32, v32, v5
    v_xor_b32 v33, v33, v5
    v_xor_b32 v34, v34, v5
    v_xor_b32 v35, v35, v5
    v_xor_b32 v36, v36, v5
    v_xor_b32 v37, v37, v5
    v_xor_b32 v38, v38, v5
    v_xor_b32 v39, v39, v5
    v_or3_b32 v20, v32, v33, v34
    v_or3_b32 v20, v20, v35, v36
    v_or3_b32 v20, v20, v37, v38
    v_or_b32 v20, v20, v39
    v_cmp_ne_u32_sdwa vcc, v20, 0 src0_sel:BYTE_0 src1_sel:DWORD
    s_cbranch_vccz L_Q0
    s_waitcnt vmcnt(3)
L_QCHK:
    v_xor_b32 v40, v40, v5
    v_xor_b32 v41, v41, v5
    v_xor_b32 v42, v42, v5
    v_xor_b32 v43, v43, v5
    v_xor_b32 v44, v44, v5
    v_xor_b32 v45, v45, v5
    v_xor_b32 v46, v46, v5
    v_xor_b32 v47, v47, v5
    v_or3_b32 v20, v40, v41, v42
    v_or3_b32 v20, v20, v43, v44
    v_or3_b32 v20, v20, v45, v46
    v_or_b32 v20, v20, v47
    v_cmp_ne_u32_sdwa vcc, v20, 0 src0_sel:BYTE_0 src1_sel:DWORD
    s_cbranch_vccz L_Q1
    s_sub_u32 s84, s84, 1
    s_cbranch_scc1 L_Q1
    buffer_load_dwordx4 v[40:43], v4, s[48:51], s89 offen offset:0 sc1
    buffer_load_dwordx4 v[44:47], v4, s[48:51], s89 offen offset:1024 sc1
    s_waitcnt vmcnt(0)
    s_branch L_QCHK
L_Q0:
    v_pk_add_f32 v[224:225], v[32:33], v[36:37]
    v_pk_add_f32 v[226:227], v[34:35], v[38:39]
    s_branch L_QC
L_Q1:
    v_pk_add_f32 v[224:225], v[40:41], v[44:45]
    v_pk_add_f32 v[226:227], v[42:43], v[46:47]
L_QC:
    s_nop 0
    v_permlane32_swap_b32 v224, v225
    v_permlane32_swap_b32 v226, v227
    v_add_f32 v224, v224, v225
    v_add_f32 v226, v226, v227
    v_cvt_pk_bf16_f32 v224, v224, v226
    ds_write_b16 v13, v224
    ds_write_b16_d16_hi v13, v224 offset:4
    s_waitcnt lgkmcnt(0)
    s_barrier
    ds_read_b128 v[24:27], v14
    s_cmp_ge_u32 s85, 1
    s_cbranch_scc1 L_B1
    buffer_load_dwordx4 v[152:155], v4, s[40:43], s67 offen offset:2048 nt
    buffer_load_dwordx4 v[156:159], v4, s[40:43], s67 offen offset:3072 nt
    buffer_load_dwordx4 v[160:163], v4, s[40:43], s71 offen offset:0 nt
L_B1:
    s_waitcnt lgkmcnt(0)
    v_mfma_f32_16x16x32_bf16 v[192:195], v[64:67], v[24:27], 0
    v_mfma_f32_16x16x32_bf16 v[196:199], v[68:71], v[24:27], 0
    v_mfma_f32_16x16x32_bf16 v[200:203], v[72:75], v[24:27], 0
    s_nop 5
    v_mov_b32_dpp v224, v192 quad_perm:[0,1,2,3] row_mask:0xf bank_mask:0x1
    s_nop 1
    v_add_f32_dpp v224, v193, v224 row_ror:12 row_mask:0xf bank_mask:0x1
    s_nop 1
    v_add_f32_dpp v224, v194, v224 row_ror:8 row_mask:0xf bank_mask:0x1
    s_nop 1
    v_add_f32_dpp v224, v195, v224 row_ror:4 row_mask:0xf bank_mask:0x1
    v_mfma_f32_16x16x32_bf16 v[204:207], v[76:79], v[24:27], 0
    v_mov_b32_dpp v224, v196 row_ror:4 row_mask:0xf bank_mask:0x2
    s_nop 1
    v_add_f32_dpp v224, v197, v224 quad_perm:[0,1,2,3] row_mask:0xf bank_mask:0x2
    s_nop 1
    v_add_f32_dpp v224, v198, v224 row_ror:12 row_mask:0xf bank_mask:0x2
    s_nop 1
    v_add_f32_dpp v224, v199, v224 row_ror:8 row_mask:0xf bank_mask:0x2
    v_mfma_f32_16x16x32_bf16 v[192:195], v[80:83], v[24:27], 0
    v_mov_b32_dpp v224, v200 row_ror:8 row_mask:0xf bank_mask:0x4
    s_nop 1
    v_add_f32_dpp v224, v201, v224 row_ror:4 row_mask:0xf bank_mask:0x4
    s_nop 1
    v_add_f32_dpp v224, v202, v224 quad_perm:[0,1,2,3] row_mask:0xf bank_mask:0x4
    s_nop 1
    v_add_f32_dpp v224, v203, v224 row_ror:12 row_mask:0xf bank_mask:0x4
    v_mfma_f32_16x16x32_bf16 v[196:199], v[84:87], v[24:27], 0
    v_mov_b32_dpp v224, v204 row_ror:12 row_mask:0xf bank_mask:0x8
    s_nop 1
    v_add_f32_dpp v224, v205, v224 row_ror:8 row_mask:0xf bank_mask:0x8
    s_nop 1
    v_add_f32_dpp v224, v206, v224 row_ror:4 row_mask:0xf bank_mask:0x8
    s_nop 1
    v_add_f32_dpp v224, v207, v224 quad_perm:[0,1,2,3] row_mask:0xf bank_mask:0x8
    v_mfma_f32_16x16x32_bf16 v[200:203], v[88:91], v[24:27], 0
    v_mov_b32_dpp v225, v192 quad_perm:[0,1,2,3] row_mask:0xf bank_mask:0x1
    s_nop 1
    v_add_f32_dpp v225, v193, v225 row_ror:12 row_mask:0xf bank_mask:0x1
    s_nop 1
    v_add_f32_dpp v225, v194, v225 row_ror:8 row_mask:0xf bank_mask:0x1
    s_nop 1
    v_add_f32_dpp v225, v195, v225 row_ror:4 row_mask:0xf bank_mask:0x1
    v_mfma_f32_16x16x32_bf16 v[204:207], v[92:95], v[24:27], 0
    v_mov_b32_dpp v225, v196 row_ror:4 row_mask:0xf bank_mask:0x2
    s_nop 1
    v_add_f32_dpp v225, v197, v225 quad_perm:[0,1,2,3] row_mask:0xf bank_mask:0x2
    s_nop 1
    v_add_f32_dpp v225, v198, v225 row_ror:12 row_mask:0xf bank_mask:0x2
    s_nop 1
    v_add_f32_dpp v225, v199, v225 row_ror:8 row_mask:0xf bank_mask:0x2
    v_mfma_f32_16x16x32_bf16 v[192:195], v[96:99], v[24:27], 0
    v_mov_b32_dpp v225, v200 row_ror:8 row_mask:0xf bank_mask:0x4
    s_nop 1
    v_add_f32_dpp v225, v201, v225 row_ror:4 row_mask:0xf bank_mask:0x4
    s_nop 1
    v_add_f32_dpp v225, v202, v225 quad_perm:[0,1,2,3] row_mask:0xf bank_mask:0x4
    s_nop 1
    v_add_f32_dpp v225, v203, v225 row_ror:12 row_mask:0xf bank_mask:0x4
    v_mfma_f32_16x16x32_bf16 v[196:199], v[100:103], v[24:27], 0
    v_mov_b32_dpp v225, v204 row_ror:12 row_mask:0xf bank_mask:0x8
    s_nop 1
    v_add_f32_dpp v225, v205, v225 row_ror:8 row_mask:0xf bank_mask:0x8
    s_nop 1
    v_add_f32_dpp v225, v206, v225 row_ror:4 row_mask:0xf bank_mask:0x8
    s_nop 1
    v_add_f32_dpp v225, v207, v225 quad_perm:[0,1,2,3] row_mask:0xf bank_mask:0x8
    v_mfma_f32_16x16x32_bf16 v[200:203], v[104:107], v[24:27], 0
    v_mov_b32_dpp v226, v192 quad_perm:[0,1,2,3] row_mask:0xf bank_mask:0x1
    s_nop 1
    v_add_f32_dpp v226, v193, v226 row_ror:12 row_mask:0xf bank_mask:0x1
    s_nop 1
    v_add_f32_dpp v226, v194, v226 row_ror:8 row_mask:0xf bank_mask:0x1
    s_nop 1
    v_add_f32_dpp v226, v195, v226 row_ror:4 row_mask:0xf bank_mask:0x1
    v_mfma_f32_16x16x32_bf16 v[204:207], v[108:111], v[24:27], 0
    v_mov_b32_dpp v226, v196 row_ror:4 row_mask:0xf bank_mask:0x2
    s_nop 1
    v_add_f32_dpp v226, v197, v226 quad_perm:[0,1,2,3] row_mask:0xf bank_mask:0x2
    s_nop 1
    v_add_f32_dpp v226, v198, v226 row_ror:12 row_mask:0xf bank_mask:0x2
    s_nop 1
    v_add_f32_dpp v226, v199, v226 row_ror:8 row_mask:0xf bank_mask:0x2
    v_mfma_f32_16x16x32_bf16 v[192:195], v[112:115], v[24:27], 0
    v_mov_b32_dpp v226, v200 row_ror:8 row_mask:0xf bank_mask:0x4
    s_nop 1
    v_add_f32_dpp v226, v201, v226 row_ror:4 row_mask:0xf bank_mask:0x4
    s_nop 1
    v_add_f32_dpp v226, v202, v226 quad_perm:[0,1,2,3] row_mask:0xf bank_mask:0x4
    s_nop 1
    v_add_f32_dpp v226, v203, v226 row_ror:12 row_mask:0xf bank_mask:0x4
    v_mfma_f32_16x16x32_bf16 v[196:199], v[116:119], v[24:27], 0
    v_mov_b32_dpp v226, v204 row_ror:12 row_mask:0xf bank_mask:0x8
    s_nop 1
    v_add_f32_dpp v226, v205, v226 row_ror:8 row_mask:0xf bank_mask:0x8
    s_nop 1
    v_add_f32_dpp v226, v206, v226 row_ror:4 row_mask:0xf bank_mask:0x8
    s_nop 1
    v_add_f32_dpp v226, v207, v226 quad_perm:[0,1,2,3] row_mask:0xf bank_mask:0x8
    v_mfma_f32_16x16x32_bf16 v[200:203], v[120:123], v[24:27], 0
    v_mov_b32_dpp v227, v192 quad_perm:[0,1,2,3] row_mask:0xf bank_mask:0x1
    s_nop 1
    v_add_f32_dpp v227, v193, v227 row_ror:12 row_mask:0xf bank_mask:0x1
    s_nop 1
    v_add_f32_dpp v227, v194, v227 row_ror:8 row_mask:0xf bank_mask:0x1
    s_nop 1
    v_add_f32_dpp v227, v195, v227 row_ror:4 row_mask:0xf bank_mask:0x1
    v_mfma_f32_16x16x32_bf16 v[204:207], v[124:127], v[24:27], 0
    v_mov_b32_dpp v227, v196 row_ror:4 row_mask:0xf bank_mask:0x2
    s_nop 1
    v_add_f32_dpp v227, v197, v227 quad_perm:[0,1,2,3] row_mask:0xf bank_mask:0x2
    s_nop 1
    v_add_f32_dpp v227, v198, v227 row_ror:12 row_mask:0xf bank_mask:0x2
    s_nop 1
    v_add_f32_dpp v227, v199, v227 row_ror:8 row_mask:0xf bank_mask:0x2
    v_mov_b32_dpp v227, v200 row_ror:8 row_mask:0xf bank_mask:0x4
    s_nop 1
    v_add_f32_dpp v227, v201, v227 row_ror:4 row_mask:0xf bank_mask:0x4
    s_nop 1
    v_add_f32_dpp v227, v202, v227 quad_perm:[0,1,2,3] row_mask:0xf bank_mask:0x4
    s_nop 1
    v_add_f32_dpp v227, v203, v227 row_ror:12 row_mask:0xf bank_mask:0x4
    v_mov_b32_dpp v227, v204 row_ror:12 row_mask:0xf bank_mask:0x8
    s_nop 1
    v_add_f32_dpp v227, v205, v227 row_ror:8 row_mask:0xf bank_mask:0x8
    s_nop 1
    v_add_f32_dpp v227, v206, v227 row_ror:4 row_mask:0xf bank_mask:0x8
    s_nop 1
    v_add_f32_dpp v227, v207, v227 quad_perm:[0,1,2,3] row_mask:0xf bank_mask:0x8
    s_cmp_ge_u32 s85, 2
    s_cbranch_scc1 L_B2
    buffer_load_dwordx4 v[164:167], v4, s[40:43], s71 offen offset:1024 nt
    buffer_load_dwordx4 v[168:171], v4, s[40:43], s71 offen offset:2048 nt
    buffer_load_dwordx4 v[172:175], v4, s[40:43], s71 offen offset:3072 nt
L_B2:
    v_cvt_pk_bf16_f32 v228, v224, v225
    v_cvt_pk_bf16_f32 v229, v226, v227
    v_lshlrev_b32 v224, 16, v228
    v_and_b32 v225, s97, v228
    v_lshlrev_b32 v226, 16, v229
    v_and_b32 v227, s97, v229
    v_pk_mul_f32 v[224:225], v[224:225], s[82:83]
    v_pk_mul_f32 v[226:227], v[226:227], s[82:83]
    v_cvt_pk_bf16_f32 v228, v224, v225
    v_cvt_pk_bf16_f32 v229, v226, v227
    v_lshlrev_b32 v224, 16, v228
    v_and_b32 v225, s97, v228
    v_lshlrev_b32 v226, 16, v229
    v_and_b32 v227, s97, v229
    v_max3_f32 v232, v224, v225, v226
    v_max_f32 v232, v232, v227
    s_nop 1
    v_max_f32_dpp v232, v232, v232 row_ror:4 row_mask:0xf bank_mask:0xf
    s_nop 1
    v_max_f32_dpp v232, v232, v232 row_ror:8 row_mask:0xf bank_mask:0xf
    ds_max_f32 v15, v232
    s_waitcnt lgkmcnt(0)
    s_barrier
    ds_read_b32 v232, v15
    s_waitcnt lgkmcnt(0)
    v_mul_f32 v228, s80, v232
    v_fma_f32 v224, v224, s80, -v228
    v_fma_f32 v225, v225, s80, -v228
    v_fma_f32 v226, v226, s80, -v228
    v_fma_f32 v227, v227, s80, -v228
    v_exp_f32 v224, v224
    v_exp_f32 v225, v225
    v_exp_f32 v226, v226
    v_exp_f32 v227, v227
    v_cvt_pk_bf16_f32 v236, v224, 0
    v_cvt_pk_bf16_f32 v228, 0, v224
    v_cvt_pk_bf16_f32 v237, v225, 0
    v_cvt_pk_bf16_f32 v229, 0, v225
    v_cvt_pk_bf16_f32 v238, v226, 0
    v_cvt_pk_bf16_f32 v230, 0, v226
    v_cvt_pk_bf16_f32 v239, v227, 0
    v_cvt_pk_bf16_f32 v231, 0, v227
    v_pk_add_f32 v[224:225], v[224:225], v[226:227]
    v_add_f32 v224, v224, v225
    s_nop 1
    v_add_f32_dpp v224, v224, v224 row_ror:4 row_mask:0xf bank_mask:0xf
    s_nop 1
    v_add_f32_dpp v224, v224, v224 row_ror:8 row_mask:0xf bank_mask:0xf
    v_mov_b32 v225, v224
    s_nop 1
    v_permlane16_swap_b32 v224, v225
    v_add_f32 v224, v224, v225
    v_mov_b32 v225, v224
    s_nop 1
    v_permlane32_swap_b32 v224, v225
    v_add_f32 v224, v224, v225
    s_mov_b64 exec, 15
    ds_write_b32 v16, v224
    s_mov_b64 exec, -1
    v_lshrrev_b32 v96, 2, v1
    v_mul_u32_u24 v96, 640, v96
    v_and_b32 v20, 3, v1
    v_lshl_add_u32 v96, v20, 4, v96
    v_lshrrev_b32 v97, 3, v1
    v_lshlrev_b32 v97, 11, v97
    v_and_b32 v20, 7, v1
    v_lshl_add_u32 v97, v20, 4, v97
    v_add_u32 v98, 16384, v97
    v_add_u32 v99, 32768, v97
    v_add_u32 v100, 49152, v97
    buffer_load_dwordx4 v[176:179], v4, s[40:43], s73 offen offset:0 nt
    v_mov_b32_dpp v208, v236 quad_perm:[0,1,2,3] row_mask:0xf bank_mask:0x1
    v_mov_b32_dpp v209, v236 row_ror:4 row_mask:0xf bank_mask:0x2
    v_mov_b32_dpp v210, v236 row_ror:8 row_mask:0xf bank_mask:0x4
    v_mov_b32_dpp v211, v236 row_ror:12 row_mask:0xf bank_mask:0x8
    s_waitcnt vmcnt(14)
    s_nop 0
    v_mfma_f32_16x16x32_bf16 v[240:243], v[128:131], v[208:211], 0
    v_mov_b32_dpp v212, v228 quad_perm:[0,1,2,3] row_mask:0xf bank_mask:0x1
    v_mov_b32_dpp v213, v228 row_ror:4 row_mask:0xf bank_mask:0x2
    v_mov_b32_dpp v214, v228 row_ror:8 row_mask:0xf bank_mask:0x4
    v_mov_b32_dpp v215, v228 row_ror:12 row_mask:0xf bank_mask:0x8
    s_nop 1
    v_mfma_f32_16x16x32_bf16 v[244:247], v[128:131], v[212:215], 0
    buffer_load_dwordx4 v[180:183], v4, s[40:43], s73 offen offset:1024 nt
    v_mov_b32_dpp v216, v236 row_ror:12 row_mask:0xf bank_mask:0x1
    v_mov_b32_dpp v217, v236 quad_perm:[0,1,2,3] row_mask:0xf bank_mask:0x2
    v_mov_b32_dpp v218, v236 row_ror:4 row_mask:0xf bank_mask:0x4
    v_mov_b32_dpp v219, v236 row_ror:8 row_mask:0xf bank_mask:0x8
    s_waitcnt vmcnt(14)
    s_nop 0
    v_mfma_f32_16x16x32_bf16 v[240:243], v[132:135], v[216:219], v[240:243]
    v_mov_b32_dpp v220, v228 row_ror:12 row_mask:0xf bank_mask:0x1
    v_mov_b32_dpp v221, v228 quad_perm:[0,1,2,3] row_mask:0xf bank_mask:0x2
    v_mov_b32_dpp v222, v228 row_ror:4 row_mask:0xf bank_mask:0x4
    v_mov_b32_dpp v223, v228 row_ror:8 row_mask:0xf bank_mask:0x8
    s_nop 1
    v_mfma_f32_16x16x32_bf16 v[244:247], v[132:135], v[220:223], v[244:247]
    buffer_load_dwordx4 v[184:187], v4, s[40:43], s73 offen offset:2048 nt
    v_mov_b32_dpp v208, v236 row_ror:8 row_mask:0xf bank_mask:0x1
    v_mov_b32_dpp v209, v236 row_ror:12 row_mask:0xf bank_mask:0x2
    v_mov_b32_dpp v210, v236 quad_perm:[0,1,2,3] row_mask:0xf bank_mask:0x4
    v_mov_b32_dpp v211, v236 row_ror:4 row_mask:0xf bank_mask:0x8
    s_waitcnt vmcnt(14)
    s_nop 0
    v_mfma_f32_16x16x32_bf16 v[240:243], v[136:139], v[208:211], v[240:243]
    v_mov_b32_dpp v212, v228 row_ror:8 row_mask:0xf bank_mask:0x1
    v_mov_b32_dpp v213, v228 row_ror:12 row_mask:0xf bank_mask:0x2
    v_mov_b32_dpp v214, v228 quad_perm:[0,1,2,3] row_mask:0xf bank_mask:0x4
    v_mov_b32_dpp v215, v228 row_ror:4 row_mask:0xf bank_mask:0x8
    s_nop 1
    v_mfma_f32_16x16x32_bf16 v[244:247], v[136:139], v[212:215], v[244:247]
    buffer_load_dwordx4 v[188:191], v4, s[40:43], s73 offen offset:3072 nt
    v_mov_b32_dpp v216, v236 row_ror:4 row_mask:0xf bank_mask:0x1
    v_mov_b32_dpp v217, v236 row_ror:8 row_mask:0xf bank_mask:0x2
    v_mov_b32_dpp v218, v236 row_ror:12 row_mask:0xf bank_mask:0x4
    v_mov_b32_dpp v219, v236 quad_perm:[0,1,2,3] row_mask:0xf bank_mask:0x8
    s_waitcnt vmcnt(12)
    s_nop 0
    v_mfma_f32_16x16x32_bf16 v[240:243], v[140:143], v[216:219], v[240:243]
    v_mov_b32_dpp v220, v228 row_ror:4 row_mask:0xf bank_mask:0x1
    v_mov_b32_dpp v221, v228 row_ror:8 row_mask:0xf bank_mask:0x2
    v_mov_b32_dpp v222, v228 row_ror:12 row_mask:0xf bank_mask:0x4
    v_mov_b32_dpp v223, v228 quad_perm:[0,1,2,3] row_mask:0xf bank_mask:0x8
    s_nop 1
    v_mfma_f32_16x16x32_bf16 v[244:247], v[140:143], v[220:223], v[244:247]
    buffer_load_dwordx4 v[32:35], v7, s[52:55], 0 offen offset:0 nt
    v_mov_b32_dpp v208, v237 quad_perm:[0,1,2,3] row_mask:0xf bank_mask:0x1
    v_mov_b32_dpp v209, v237 row_ror:4 row_mask:0xf bank_mask:0x2
    v_mov_b32_dpp v210, v237 row_ror:8 row_mask:0xf bank_mask:0x4
    v_mov_b32_dpp v211, v237 row_ror:12 row_mask:0xf bank_mask:0x8
    s_waitcnt vmcnt(12)
    s_nop 0
    v_mfma_f32_16x16x32_bf16 v[240:243], v[144:147], v[208:211], v[240:243]
    v_mov_b32_dpp v212, v229 quad_perm:[0,1,2,3] row_mask:0xf bank_mask:0x1
    v_mov_b32_dpp v213, v229 row_ror:4 row_mask:0xf bank_mask:0x2
    v_mov_b32_dpp v214, v229 row_ror:8 row_mask:0xf bank_mask:0x4
    v_mov_b32_dpp v215, v229 row_ror:12 row_mask:0xf bank_mask:0x8
    s_nop 1
    v_mfma_f32_16x16x32_bf16 v[244:247], v[144:147], v[212:215], v[244:247]
    buffer_load_dwordx4 v[36:39], v7, s[52:55], 0 offen offset:256 nt
    v_mov_b32_dpp v216, v237 row_ror:12 row_mask:0xf bank_mask:0x1
    v_mov_b32_dpp v217, v237 quad_perm:[0,1,2,3] row_mask:0xf bank_mask:0x2
    v_mov_b32_dpp v218, v237 row_ror:4 row_mask:0xf bank_mask:0x4
    v_mov_b32_dpp v219, v237 row_ror:8 row_mask:0xf bank_mask:0x8
    s_waitcnt vmcnt(12)
    s_nop 0
    v_mfma_f32_16x16x32_bf16 v[240:243], v[148:151], v[216:219], v[240:243]
    v_mov_b32_dpp v220, v229 row_ror:12 row_mask:0xf bank_mask:0x1
    v_mov_b32_dpp v221, v229 quad_perm:[0,1,2,3] row_mask:0xf bank_mask:0x2
    v_mov_b32_dpp v222, v229 row_ror:4 row_mask:0xf bank_mask:0x4
    v_mov_b32_dpp v223, v229 row_ror:8 row_mask:0xf bank_mask:0x8
    s_nop 1
    v_mfma_f32_16x16x32_bf16 v[244:247], v[148:151], v[220:223], v[244:247]
    buffer_load_dwordx4 v[40:43], v7, s[52:55], s64 offen offset:0 nt
    v_mov_b32_dpp v208, v237 row_ror:8 row_mask:0xf bank_mask:0x1
    v_mov_b32_dpp v209, v237 row_ror:12 row_mask:0xf bank_mask:0x2
    v_mov_b32_dpp v210, v237 quad_perm:[0,1,2,3] row_mask:0xf bank_mask:0x4
    v_mov_b32_dpp v211, v237 row_ror:4 row_mask:0xf bank_mask:0x8
    s_waitcnt vmcnt(12)
    s_nop 0
    v_mfma_f32_16x16x32_bf16 v[240:243], v[152:155], v[208:211], v[240:243]
    v_mov_b32_dpp v212, v229 row_ror:8 row_mask:0xf bank_mask:0x1
    v_mov_b32_dpp v213, v229 row_ror:12 row_mask:0xf bank_mask:0x2
    v_mov_b32_dpp v214, v229 quad_perm:[0,1,2,3] row_mask:0xf bank_mask:0x4
    v_mov_b32_dpp v215, v229 row_ror:4 row_mask:0xf bank_mask:0x8
    s_nop 1
    v_mfma_f32_16x16x32_bf16 v[244:247], v[152:155], v[212:215], v[244:247]
    buffer_load_dwordx4 v[44:47], v7, s[52:55], s64 offen offset:256 nt
    v_mov_b32_dpp v216, v237 row_ror:4 row_mask:0xf bank_mask:0x1
    v_mov_b32_dpp v217, v237 row_ror:8 row_mask:0xf bank_mask:0x2
    v_mov_b32_dpp v218, v237 row_ror:12 row_mask:0xf bank_mask:0x4
    v_mov_b32_dpp v219, v237 quad_perm:[0,1,2,3] row_mask:0xf bank_mask:0x8
    s_waitcnt vmcnt(12)
    s_nop 0
    v_mfma_f32_16x16x32_bf16 v[240:243], v[156:159], v[216:219], v[240:243]
    v_mov_b32_dpp v220, v229 row_ror:4 row_mask:0xf bank_mask:0x1
    v_mov_b32_dpp v221, v229 row_ror:8 row_mask:0xf bank_mask:0x2
    v_mov_b32_dpp v222, v229 row_ror:12 row_mask:0xf bank_mask:0x4
    v_mov_b32_dpp v223, v229 quad_perm:[0,1,2,3] row_mask:0xf bank_mask:0x8
    s_nop 1
    v_mfma_f32_16x16x32_bf16 v[244:247], v[156:159], v[220:223], v[244:247]
    buffer_load_dwordx4 v[48:51], v7, s[52:55], s65 offen offset:0 nt
    v_mov_b32_dpp v208, v238 quad_perm:[0,1,2,3] row_mask:0xf bank_mask:0x1
    v_mov_b32_dpp v209, v238 row_ror:4 row_mask:0xf bank_mask:0x2
    v_mov_b32_dpp v210, v238 row_ror:8 row_mask:0xf bank_mask:0x4
    v_mov_b32_dpp v211, v238 row_ror:12 row_mask:0xf bank_mask:0x8
    s_waitcnt vmcnt(12)
    s_nop 0
    v_mfma_f32_16x16x32_bf16 v[240:243], v[160:163], v[208:211], v[240:243]
    v_mov_b32_dpp v212, v230 quad_perm:[0,1,2,3] row_mask:0xf bank_mask:0x1
    v_mov_b32_dpp v213, v230 row_ror:4 row_mask:0xf bank_mask:0x2
    v_mov_b32_dpp v214, v230 row_ror:8 row_mask:0xf bank_mask:0x4
    v_mov_b32_dpp v215, v230 row_ror:12 row_mask:0xf bank_mask:0x8
    s_nop 1
    v_mfma_f32_16x16x32_bf16 v[244:247], v[160:163], v[212:215], v[244:247]
    buffer_load_dwordx4 v[52:55], v7, s[52:55], s65 offen offset:256 nt
    v_mov_b32_dpp v216, v238 row_ror:12 row_mask:0xf bank_mask:0x1
    v_mov_b32_dpp v217, v238 quad_perm:[0,1,2,3] row_mask:0xf bank_mask:0x2
    v_mov_b32_dpp v218, v238 row_ror:4 row_mask:0xf bank_mask:0x4
    v_mov_b32_dpp v219, v238 row_ror:8 row_mask:0xf bank_mask:0x8
    s_waitcnt vmcnt(12)
    s_nop 0
    v_mfma_f32_16x16x32_bf16 v[240:243], v[164:167], v[216:219], v[240:243]
    v_mov_b32_dpp v220, v230 row_ror:12 row_mask:0xf bank_mask:0x1
    v_mov_b32_dpp v221, v230 quad_perm:[0,1,2,3] row_mask:0xf bank_mask:0x2
    v_mov_b32_dpp v222, v230 row_ror:4 row_mask:0xf bank_mask:0x4
    v_mov_b32_dpp v223, v230 row_ror:8 row_mask:0xf bank_mask:0x8
    s_nop 1
    v_mfma_f32_16x16x32_bf16 v[244:247], v[164:167], v[220:223], v[244:247]
    buffer_load_dwordx4 v[56:59], v7, s[52:55], s66 offen offset:0 nt
    v_mov_b32_dpp v208, v238 row_ror:8 row_mask:0xf bank_mask:0x1
    v_mov_b32_dpp v209, v238 row_ror:12 row_mask:0xf bank_mask:0x2
    v_mov_b32_dpp v210, v238 quad_perm:[0,1,2,3] row_mask:0xf bank_mask:0x4
    v_mov_b32_dpp v211, v238 row_ror:4 row_mask:0xf bank_mask:0x8
    s_waitcnt vmcnt(12)
    s_nop 0
    v_mfma_f32_16x16x32_bf16 v[240:243], v[168:171], v[208:211], v[240:243]
    v_mov_b32_dpp v212, v230 row_ror:8 row_mask:0xf bank_mask:0x1
    v_mov_b32_dpp v213, v230 row_ror:12 row_mask:0xf bank_mask:0x2
    v_mov_b32_dpp v214, v230 quad_perm:[0,1,2,3] row_mask:0xf bank_mask:0x4
    v_mov_b32_dpp v215, v230 row_ror:4 row_mask:0xf bank_mask:0x8
    s_nop 1
    v_mfma_f32_16x16x32_bf16 v[244:247], v[168:171], v[212:215], v[244:247]
    buffer_load_dwordx4 v[60:63], v7, s[52:55], s66 offen offset:256 nt
    v_mov_b32_dpp v216, v238 row_ror:4 row_mask:0xf bank_mask:0x1
    v_mov_b32_dpp v217, v238 row_ror:8 row_mask:0xf bank_mask:0x2
    v_mov_b32_dpp v218, v238 row_ror:12 row_mask:0xf bank_mask:0x4
    v_mov_b32_dpp v219, v238 quad_perm:[0,1,2,3] row_mask:0xf bank_mask:0x8
    s_waitcnt vmcnt(12)
    s_nop 0
    v_mfma_f32_16x16x32_bf16 v[240:243], v[172:175], v[216:219], v[240:243]
    v_mov_b32_dpp v220, v230 row_ror:4 row_mask:0xf bank_mask:0x1
    v_mov_b32_dpp v221, v230 row_ror:8 row_mask:0xf bank_mask:0x2
    v_mov_b32_dpp v222, v230 row_ror:12 row_mask:0xf bank_mask:0x4
    v_mov_b32_dpp v223, v230 quad_perm:[0,1,2,3] row_mask:0xf bank_mask:0x8
    s_nop 1
    v_mfma_f32_16x16x32_bf16 v[244:247], v[172:175], v[220:223], v[244:247]
    v_mov_b32_dpp v208, v239 quad_perm:[0,1,2,3] row_mask:0xf bank_mask:0x1
    v_mov_b32_dpp v209, v239 row_ror:4 row_mask:0xf bank_mask:0x2
    v_mov_b32_dpp v210, v239 row_ror:8 row_mask:0xf bank_mask:0x4
    v_mov_b32_dpp v211, v239 row_ror:12 row_mask:0xf bank_mask:0x8
    s_waitcnt vmcnt(11)
    s_nop 0
    v_mfma_f32_16x16x32_bf16 v[240:243], v[176:179], v[208:211], v[240:243]
    v_mov_b32_dpp v212, v231 quad_perm:[0,1,2,3] row_mask:0xf bank_mask:0x1
    v_mov_b32_dpp v213, v231 row_ror:4 row_mask:0xf bank_mask:0x2
    v_mov_b32_dpp v214, v231 row_ror:8 row_mask:0xf bank_mask:0x4
    v_mov_b32_dpp v215, v231 row_ror:12 row_mask:0xf bank_mask:0x8
    s_nop 1
    v_mfma_f32_16x16x32_bf16 v[244:247], v[176:179], v[212:215], v[244:247]
    v_mov_b32_dpp v216, v239 row_ror:12 row_mask:0xf bank_mask:0x1
    v_mov_b32_dpp v217, v239 quad_perm:[0,1,2,3] row_mask:0xf bank_mask:0x2
    v_mov_b32_dpp v218, v239 row_ror:4 row_mask:0xf bank_mask:0x4
    v_mov_b32_dpp v219, v239 row_ror:8 row_mask:0xf bank_mask:0x8
    s_waitcnt vmcnt(10)
    s_nop 0
    v_mfma_f32_16x16x32_bf16 v[240:243], v[180:183], v[216:219], v[240:243]
    v_mov_b32_dpp v220, v231 row_ror:12 row_mask:0xf bank_mask:0x1
    v_mov_b32_dpp v221, v231 quad_perm:[0,1,2,3] row_mask:0xf bank_mask:0x2
    v_mov_b32_dpp v222, v231 row_ror:4 row_mask:0xf bank_mask:0x4
    v_mov_b32_dpp v223, v231 row_ror:8 row_mask:0xf bank_mask:0x8
    s_nop 1
    v_mfma_f32_16x16x32_bf16 v[244:247], v[180:183], v[220:223], v[244:247]
    v_mov_b32_dpp v208, v239 row_ror:8 row_mask:0xf bank_mask:0x1
    v_mov_b32_dpp v209, v239 row_ror:12 row_mask:0xf bank_mask:0x2
    v_mov_b32_dpp v210, v239 quad_perm:[0,1,2,3] row_mask:0xf bank_mask:0x4
    v_mov_b32_dpp v211, v239 row_ror:4 row_mask:0xf bank_mask:0x8
    s_waitcnt vmcnt(9)
    s_nop 0
    v_mfma_f32_16x16x32_bf16 v[240:243], v[184:187], v[208:211], v[240:243]
    v_mov_b32_dpp v212, v231 row_ror:8 row_mask:0xf bank_mask:0x1
    v_mov_b32_dpp v213, v231 row_ror:12 row_mask:0xf bank_mask:0x2
    v_mov_b32_dpp v214, v231 quad_perm:[0,1,2,3] row_mask:0xf bank_mask:0x4
    v_mov_b32_dpp v215, v231 row_ror:4 row_mask:0xf bank_mask:0x8
    s_nop 1
    v_mfma_f32_16x16x32_bf16 v[244:247], v[184:187], v[212:215], v[244:247]
    v_mov_b32_dpp v216, v239 row_ror:4 row_mask:0xf bank_mask:0x1
    v_mov_b32_dpp v217, v239 row_ror:8 row_mask:0xf bank_mask:0x2
    v_mov_b32_dpp v218, v239 row_ror:12 row_mask:0xf bank_mask:0x4
    v_mov_b32_dpp v219, v239 quad_perm:[0,1,2,3] row_mask:0xf bank_mask:0x8
    s_waitcnt vmcnt(8)
    s_nop 0
    v_mfma_f32_16x16x32_bf16 v[240:243], v[188:191], v[216:219], v[240:243]
    v_mov_b32_dpp v220, v231 row_ror:4 row_mask:0xf bank_mask:0x1
    v_mov_b32_dpp v221, v231 row_ror:8 row_mask:0xf bank_mask:0x2
    v_mov_b32_dpp v222, v231 row_ror:12 row_mask:0xf bank_mask:0x4
    v_mov_b32_dpp v223, v231 quad_perm:[0,1,2,3] row_mask:0xf bank_mask:0x8
    s_nop 1
    v_mfma_f32_16x16x32_bf16 v[244:247], v[188:191], v[220:223], v[244:247]
    s_nop 7
    ds_write2_b32 v17, v240, v244 offset0:0 offset1:1
    ds_write2_b32 v17, v241, v245 offset0:8 offset1:9
    ds_write2_b32 v17, v242, v246 offset0:16 offset1:17
    ds_write2_b32 v17, v243, v247 offset0:24 offset1:25
    s_waitcnt lgkmcnt(0)
    s_barrier
    s_mov_b32 exec_hi, 0xff
    ds_read_b128 v[192:195], v18 offset:0
    ds_read_b128 v[196:199], v18 offset:2176
    ds_read_b128 v[200:203], v18 offset:4352
    ds_read_b128 v[204:207], v18 offset:6528
    s_lshl_b32 s98, s77, 4
    v_mov_b32 v23, s98
    s_lshl_b32 s98, s77, 2
    v_mov_b32 v24, s98
    ds_read_b128 v[208:211], v23 offset:5280
    ds_read_b32 v212, v24 offset:5248
    s_waitcnt lgkmcnt(2)
    v_pk_add_f32 v[192:193], v[192:193], v[196:197]
    v_pk_add_f32 v[194:195], v[194:195], v[198:199]
    v_pk_add_f32 v[200:201], v[200:201], v[204:205]
    v_pk_add_f32 v[202:203], v[202:203], v[206:207]
    v_pk_add_f32 v[192:193], v[192:193], v[200:201]
    v_pk_add_f32 v[194:195], v[194:195], v[202:203]
    v_and_or_b32 v192, v192, s79, v5
    v_and_or_b32 v193, v193, s79, v5
    v_and_or_b32 v194, v194, s79, v5
    v_and_or_b32 v195, v195, s79, v5
    s_waitcnt lgkmcnt(0)
    v_pk_add_f32 v[208:209], v[208:209], v[210:211]
    s_mov_b32 exec_lo, 0
    v_add_f32 v208, v208, v209
    v_or_b32 v192, v212, v5
    v_mov_b32 v194, v5
    v_mov_b32 v195, v5
    v_and_or_b32 v193, v208, s79, v5
    s_mov_b32 exec_lo, -1
    buffer_store_dwordx4 v[192:195], v19, s[48:51], s90 offen sc1
    s_mov_b32 exec_hi, -1
    buffer_load_dwordx4 v[224:227], v96, s[48:51], s93 offen sc1
    s_min_u32 s84, s84, 20000
L_OCHK:
    s_waitcnt vmcnt(0)
    v_xor_b32 v224, v224, v5
    v_xor_b32 v225, v225, v5
    v_xor_b32 v226, v226, v5
    v_xor_b32 v227, v227, v5
    v_or3_b32 v20, v224, v225, v226
    v_or_b32 v20, v20, v227
    v_cmp_ne_u32_sdwa vcc, v20, 0 src0_sel:BYTE_0 src1_sel:DWORD
    s_cbranch_vccz L_OS
    buffer_load_dwordx4 v[224:227], v96, s[48:51], s93 offen sc1
    s_sub_u32 s84, s84, 1
    s_cbranch_scc0 L_OCHK
L_OS:
    buffer_load_dwordx4 v[228:231], v96, s[48:51], s91 offen sc1
    s_min_u32 s84, s84, 20000
    v_max_f32_dpp v20, v224, v224 row_ror:4 row_mask:0xf bank_mask:0xf
    s_nop 1
    v_max_f32_dpp v20, v20, v20 row_ror:8 row_mask:0xf bank_mask:0xf
    v_mov_b32 v21, v20
    s_nop 1
    v_permlane16_swap_b32 v20, v21
    v_max_f32 v20, v20, v21
    v_mov_b32 v21, v20
    s_nop 1
    v_permlane32_swap_b32 v20, v21
    v_max_f32 v20, v20, v21
    v_mul_f32 v20, s80, v20
    v_fma_f32 v224, v224, s80, -v20
    v_exp_f32 v224, v224
    s_nop 0
    v_mul_f32 v20, v224, v225
    v_mov_b32 v225, v224
L_OCHK2:
    s_waitcnt vmcnt(0)
    v_xor_b32 v228, v228, v5
    v_xor_b32 v229, v229, v5
    v_xor_b32 v230, v230, v5
    v_xor_b32 v231, v231, v5
    v_or3_b32 v22, v228, v229, v230
    v_or_b32 v22, v22, v231
    v_cmp_ne_u32_sdwa vcc, v22, 0 src0_sel:BYTE_0 src1_sel:DWORD
    s_cbranch_vccz L_OO
    buffer_load_dwordx4 v[228:231], v96, s[48:51], s91 offen sc1
    s_sub_u32 s84, s84, 1
    s_cbranch_scc0 L_OCHK2
L_OO:
    v_pk_mul_f32 v[240:241], v[228:229], v[224:225]
    v_pk_mul_f32 v[242:243], v[230:231], v[224:225]
    v_add_f32_dpp v20, v20, v20 row_ror:4 row_mask:0xf bank_mask:0xf
L_OOK:
    v_permlane32_swap_b32 v240, v241
    s_nop 0
    v_add_f32_dpp v20, v20, v20 row_ror:8 row_mask:0xf bank_mask:0xf
    v_permlane32_swap_b32 v242, v243
    v_mov_b32 v21, v20
    v_add_f32 v240, v240, v241
    s_nop 0
    v_permlane16_swap_b32 v20, v21
    v_add_f32 v242, v242, v243
    v_add_f32 v20, v20, v21
    s_nop 0
    v_permlane16_swap_b32 v240, v242
    v_mov_b32 v21, v20
    v_add_f32 v240, v240, v242
    s_nop 0
    v_permlane32_swap_b32 v20, v21
    v_add_f32_dpp v240, v240, v240 row_ror:4 row_mask:0xf bank_mask:0xf
    v_add_f32 v20, v20, v21
    s_nop 0
    v_add_f32_dpp v240, v240, v240 row_ror:8 row_mask:0xf bank_mask:0xf
    v_rcp_f32 v20, v20
    s_nop 0
    v_mul_f32 v240, v240, v20
    v_cvt_pk_bf16_f32 v240, v240, v240
    s_cmp_ge_u32 s81, 16
    s_cbranch_scc1 L_FE_DONE
    buffer_load_dwordx4 v[64:67], v97, s[48:51], s95 offen sc1
    buffer_load_dwordx4 v[68:71], v98, s[48:51], s95 offen sc1
    buffer_load_dwordx4 v[72:75], v99, s[48:51], s95 offen sc1
    buffer_load_dwordx4 v[76:79], v100, s[48:51], s95 offen sc1
L_FE_DONE:
    v_and_b32_dpp v192, v240, v8 row_newbcast:0 row_mask:0xf bank_mask:0xf
    v_and_b32_dpp v193, v240, v9 row_newbcast:0 row_mask:0xf bank_mask:0xf
    v_and_b32_dpp v194, v240, v10 row_newbcast:0 row_mask:0xf bank_mask:0xf
    v_and_b32_dpp v195, v240, v11 row_newbcast:0 row_mask:0xf bank_mask:0xf
    v_and_b32_dpp v196, v240, v28 row_newbcast:0 row_mask:0xf bank_mask:0xf
    v_and_b32_dpp v197, v240, v29 row_newbcast:0 row_mask:0xf bank_mask:0xf
    v_and_b32_dpp v198, v240, v30 row_newbcast:0 row_mask:0xf bank_mask:0xf
    v_and_b32_dpp v199, v240, v31 row_newbcast:0 row_mask:0xf bank_mask:0xf
    v_mfma_f32_16x16x32_bf16 v[24:27], v[192:195], v[32:35], 0
    v_and_b32_dpp v200, v240, v8 row_newbcast:1 row_mask:0xf bank_mask:0xf
    v_and_b32_dpp v201, v240, v9 row_newbcast:1 row_mask:0xf bank_mask:0xf
    v_and_b32_dpp v202, v240, v10 row_newbcast:1 row_mask:0xf bank_mask:0xf
    v_and_b32_dpp v203, v240, v11 row_newbcast:1 row_mask:0xf bank_mask:0xf
    v_mfma_f32_16x16x32_bf16 v[24:27], v[196:199], v[36:39], v[24:27]
    v_and_b32_dpp v204, v240, v28 row_newbcast:1 row_mask:0xf bank_mask:0xf
    v_and_b32_dpp v205, v240, v29 row_newbcast:1 row_mask:0xf bank_mask:0xf
    v_and_b32_dpp v206, v240, v30 row_newbcast:1 row_mask:0xf bank_mask:0xf
    v_and_b32_dpp v207, v240, v31 row_newbcast:1 row_mask:0xf bank_mask:0xf
    v_mfma_f32_16x16x32_bf16 v[24:27], v[200:203], v[40:43], v[24:27]
    v_and_b32_dpp v208, v240, v8 row_newbcast:2 row_mask:0xf bank_mask:0xf
    v_and_b32_dpp v209, v240, v9 row_newbcast:2 row_mask:0xf bank_mask:0xf
    v_and_b32_dpp v210, v240, v10 row_newbcast:2 row_mask:0xf bank_mask:0xf
    v_and_b32_dpp v211, v240, v11 row_newbcast:2 row_mask:0xf bank_mask:0xf
    v_mfma_f32_16x16x32_bf16 v[24:27], v[204:207], v[44:47], v[24:27]
    v_and_b32_dpp v212, v240, v28 row_newbcast:2 row_mask:0xf bank_mask:0xf
    v_and_b32_dpp v213, v240, v29 row_newbcast:2 row_mask:0xf bank_mask:0xf
    v_and_b32_dpp v214, v240, v30 row_newbcast:2 row_mask:0xf bank_mask:0xf
    v_and_b32_dpp v215, v240, v31 row_newbcast:2 row_mask:0xf bank_mask:0xf
    v_mfma_f32_16x16x32_bf16 v[24:27], v[208:211], v[48:51], v[24:27]
    v_and_b32_dpp v216, v240, v8 row_newbcast:3 row_mask:0xf bank_mask:0xf
    v_and_b32_dpp v217, v240, v9 row_newbcast:3 row_mask:0xf bank_mask:0xf
    v_and_b32_dpp v218, v240, v10 row_newbcast:3 row_mask:0xf bank_mask:0xf
    v_and_b32_dpp v219, v240, v11 row_newbcast:3 row_mask:0xf bank_mask:0xf
    v_mfma_f32_16x16x32_bf16 v[24:27], v[212:215], v[52:55], v[24:27]
    v_and_b32_dpp v220, v240, v28 row_newbcast:3 row_mask:0xf bank_mask:0xf
    v_and_b32_dpp v221, v240, v29 row_newbcast:3 row_mask:0xf bank_mask:0xf
    v_and_b32_dpp v222, v240, v30 row_newbcast:3 row_mask:0xf bank_mask:0xf
    v_and_b32_dpp v223, v240, v31 row_newbcast:3 row_mask:0xf bank_mask:0xf
    v_mfma_f32_16x16x32_bf16 v[24:27], v[216:219], v[56:59], v[24:27]
    s_nop 0
    v_mfma_f32_16x16x32_bf16 v[24:27], v[220:223], v[60:63], v[24:27]
    v_lshrrev_b32 v20, 5, v1
    v_lshlrev_b32 v20, 9, v20
    v_and_b32 v21, 15, v1
    v_lshl_or_b32 v20, v21, 5, v20
    v_bfe_u32 v21, v1, 4, 1
    v_lshl_or_b32 v20, v21, 4, v20
    s_lshl_b32 s98, s77, 10
    v_add_u32 v20, s98, v20
    ds_write_b128 v20, v[24:27] offset:0
    s_waitcnt lgkmcnt(0)
    s_barrier
    s_cmp_lg_u32 s77, 0
    s_cbranch_scc1 L_APUB_DONE
    ds_read_b128 v[192:195], v19 offset:0
    ds_read_b128 v[196:199], v19 offset:1024
    ds_read_b128 v[200:203], v19 offset:2048
    ds_read_b128 v[204:207], v19 offset:3072
    s_waitcnt lgkmcnt(0)
    v_pk_add_f32 v[192:193], v[192:193], v[196:197]
    v_pk_add_f32 v[194:195], v[194:195], v[198:199]
    v_pk_add_f32 v[200:201], v[200:201], v[204:205]
    v_pk_add_f32 v[202:203], v[202:203], v[206:207]
    v_pk_add_f32 v[192:193], v[192:193], v[200:201]
    v_pk_add_f32 v[194:195], v[194:195], v[202:203]
    v_and_or_b32 v192, v192, s79, v5
    v_and_or_b32 v193, v193, s79, v5
    v_and_or_b32 v194, v194, s79, v5
    v_and_or_b32 v195, v195, s79, v5
    buffer_store_dwordx4 v[192:195], v19, s[48:51], s94 offen sc1
L_APUB_DONE:
    s_nop 1
    s_cmp_ge_u32 s81, 16
    s_cbranch_scc1 L_FIN_DONE
    buffer_load_dwordx4 v[80:83], v97, s[48:51], s95 offen sc1
    buffer_load_dwordx4 v[84:87], v98, s[48:51], s95 offen sc1
    buffer_load_dwordx4 v[88:91], v99, s[48:51], s95 offen sc1
    buffer_load_dwordx4 v[92:95], v100, s[48:51], s95 offen sc1
    s_cmp_lt_u32 s77, 2
    s_cbranch_scc1 L_FCO
    v_mov_b32 v248, v250
L_FCO:
    v_and_b32 v21, 7, v1
    v_lshlrev_b32 v21, 4, v21
    v_bfe_u32 v22, v7, 10, 2
    v_lshl_add_u32 v21, v22, 2, v21
    s_lshl_b32 s98, s77, 7
    v_add_u32 v21, s98, v21
    v_lshlrev_b32 v22, 2, v1
    v_lshlrev_b32 v23, 1, v1
    s_min_u32 s84, s84, 20000
L_FG:
    s_waitcnt vmcnt(4)
    v_xor_b32 v64, v64, v5
    v_xor_b32 v65, v65, v5
    v_xor_b32 v66, v66, v5
    v_xor_b32 v67, v67, v5
    v_xor_b32 v68, v68, v5
    v_xor_b32 v69, v69, v5
    v_xor_b32 v70, v70, v5
    v_xor_b32 v71, v71, v5
    v_xor_b32 v72, v72, v5
    v_xor_b32 v73, v73, v5
    v_xor_b32 v74, v74, v5
    v_xor_b32 v75, v75, v5
    v_xor_b32 v76, v76, v5
    v_xor_b32 v77, v77, v5
    v_xor_b32 v78, v78, v5
    v_xor_b32 v79, v79, v5
    v_or3_b32 v20, v64, v65, v66
    v_or3_b32 v20, v20, v67, v68
    v_or3_b32 v20, v20, v69, v70
    v_or3_b32 v20, v20, v71, v72
    v_or3_b32 v20, v20, v73, v74
    v_or3_b32 v20, v20, v75, v76
    v_or3_b32 v20, v20, v77, v78
    v_or_b32 v20, v20, v79
    v_cmp_ne_u32_sdwa vcc, v20, 0 src0_sel:BYTE_0 src1_sel:DWORD
    s_cbranch_vccz L_FA
    buffer_load_dwordx4 v[64:67], v97, s[48:51], s95 offen sc1
    buffer_load_dwordx4 v[68:71], v98, s[48:51], s95 offen sc1
    buffer_load_dwordx4 v[72:75], v99, s[48:51], s95 offen sc1
    buffer_load_dwordx4 v[76:79], v100, s[48:51], s95 offen sc1
    s_waitcnt vmcnt(4)
    v_xor_b32 v80, v80, v5
    v_xor_b32 v81, v81, v5
    v_xor_b32 v82, v82, v5
    v_xor_b32 v83, v83, v5
    v_xor_b32 v84, v84, v5
    v_xor_b32 v85, v85, v5
    v_xor_b32 v86, v86, v5
    v_xor_b32 v87, v87, v5
    v_xor_b32 v88, v88, v5
    v_xor_b32 v89, v89, v5
    v_xor_b32 v90, v90, v5
    v_xor_b32 v91, v91, v5
    v_xor_b32 v92, v92, v5
    v_xor_b32 v93, v93, v5
    v_xor_b32 v94, v94, v5
    v_xor_b32 v95, v95, v5
    v_or3_b32 v20, v80, v81, v82
    v_or3_b32 v20, v20, v83, v84
    v_or3_b32 v20, v20, v85, v86
    v_or3_b32 v20, v20, v87, v88
    v_or3_b32 v20, v20, v89, v90
    v_or3_b32 v20, v20, v91, v92
    v_or3_b32 v20, v20, v93, v94
    v_or_b32 v20, v20, v95
    v_cmp_ne_u32_sdwa vcc, v20, 0 src0_sel:BYTE_0 src1_sel:DWORD
    s_cbranch_vccz L_FB
    buffer_load_dwordx4 v[80:83], v97, s[48:51], s95 offen sc1
    buffer_load_dwordx4 v[84:87], v98, s[48:51], s95 offen sc1
    buffer_load_dwordx4 v[88:91], v99, s[48:51], s95 offen sc1
    buffer_load_dwordx4 v[92:95], v100, s[48:51], s95 offen sc1
    s_sub_u32 s84, s84, 1
    s_cbranch_scc0 L_FG
L_FB:
    v_pk_add_f32 v[80:81], v[80:81], v[84:85]
    v_pk_add_f32 v[82:83], v[82:83], v[86:87]
    v_pk_add_f32 v[88:89], v[88:89], v[92:93]
    v_pk_add_f32 v[90:91], v[90:91], v[94:95]
    v_pk_add_f32 v[240:241], v[80:81], v[88:89]
    v_pk_add_f32 v[242:243], v[82:83], v[90:91]
    s_branch L_FOK
L_FA:
    v_pk_add_f32 v[64:65], v[64:65], v[68:69]
    v_pk_add_f32 v[66:67], v[66:67], v[70:71]
    v_pk_add_f32 v[72:73], v[72:73], v[76:77]
    v_pk_add_f32 v[74:75], v[74:75], v[78:79]
    v_pk_add_f32 v[240:241], v[64:65], v[72:73]
    v_pk_add_f32 v[242:243], v[66:67], v[74:75]
L_FOK:
    s_nop 0
    v_permlane32_swap_b32 v240, v241
    v_permlane32_swap_b32 v242, v243
    v_add_f32 v240, v240, v241
    v_add_f32 v242, v242, v243
    s_nop 1
    v_permlane16_swap_b32 v240, v242
    v_add_f32 v240, v240, v242
    s_nop 1
    v_add_f32_dpp v240, v240, v240 row_ror:8 row_mask:0xf bank_mask:0xf
    v_mul_f32 v240, v240, v248
    ds_write_b32 v21, v240 offset:4096
    s_waitcnt lgkmcnt(0)
    s_barrier
    s_cmp_lg_u32 s77, 0
    s_cbranch_scc1 L_FIN_DONE
    s_mov_b32 exec_hi, 0
    v_add_u32 v22, 4096, v22
    ds_read2_b32 v[240:241], v22 offset0:0 offset1:32
    ds_read2_b32 v[242:243], v22 offset0:64 offset1:96
    s_lshl_b32 s99, s81, 6
    s_waitcnt lgkmcnt(0)
    v_pk_add_f32 v[240:241], v[240:241], v[242:243]
    v_add_f32 v240, v240, v241
    v_cvt_pk_bf16_f32 v240, v240, v240
    buffer_store_short v240, v23, s[60:63], s99 offen
    s_cmp_lg_u32 s81, 0
    s_cbranch_scc1 L_FIN_DONE
    v_mov_b32 v22, s78
    v_mov_b32 v23, 0
    s_mov_b64 exec, 1
    buffer_store_dword v22, v23, s[48:51], 0 offen sc1
L_FIN_DONE:
    s_mov_b64 exec, -1
L_END:
    s_endpgm

.section .rodata,"a"
.p2align 6
.amdhsa_kernel gated_mix__sliding_block_cached__sliding_block_cached__decode_kernel
  .amdhsa_next_free_vgpr 256
  .amdhsa_next_free_sgpr 102
  .amdhsa_accum_offset 256
  .amdhsa_group_segment_fixed_size 0
  .amdhsa_kernarg_size 112
  .amdhsa_user_sgpr_count 2
  .amdhsa_user_sgpr_kernarg_segment_ptr 1
  .amdhsa_system_sgpr_workgroup_id_x 1
.end_amdhsa_kernel
```
